```python
import torch

def _softmax(x, axis=-1):
    return torch.softmax(x, dim=axis)
def _gelu(x):
    return torch.nn.functional.gelu(x, approximate="tanh")
def _silu(x):
    return torch.nn.functional.silu(x)
def _sigmoid(x):
    return torch.sigmoid(x)
def _layernorm(x, axis=-1, eps=1e-5):
    m = x.mean(dim=axis, keepdim=True)
    v = x.var(dim=axis, keepdim=True, unbiased=False)
    return (x - m) / torch.sqrt(v + eps)
def _scatter_add(tgt, idx, src, axis=0):
    return tgt.clone().index_add_(axis, idx, src)
def _segment_sum(src, seg, n):
    out = torch.zeros((n,) + src.shape[1:], dtype=src.dtype)
    return out.index_add_(0, seg, src)
def _pad(x, pw):
    flat = tuple(v for pair in reversed(pw) for v in pair)
    return torch.nn.functional.pad(x, flat)

kernel_name = 'standalone__linear_kernel_rfa__decode'

def setup_inputs():

    _w = (lambda a: (lambda t: t.to(torch.bfloat16) if t.is_floating_point() else t)(torch.as_tensor(a)))
    B, H, Sq, Sk, D, M = 8, 32, 1, 4096, 128, 64
    return {
        "q": _w((lambda *s: torch.randn(*s, dtype=torch.bfloat16) * 0.2)(B, H, Sq, D)),
        "k": _w((lambda *s: torch.randn(*s, dtype=torch.bfloat16) * 1.6)(B, H, Sk, D)),
        "v": _w((lambda *s: torch.randn(*s, dtype=torch.bfloat16) * 1.6)(B, H, Sk, D)),
        "omega": _w((lambda *s: torch.randn(*s, dtype=torch.bfloat16) * 1.6)(M, D)),
    }

def reference(q, k, v, omega):
    d = q.shape[-1]
    m = omega.shape[0]
    scale = float(d) ** -0.25
    qs = q * scale
    ks = k * scale
    q_proj = torch.einsum("bhsd,md->bhsm", qs, omega)
    k_proj = torch.einsum("bhsd,md->bhsm", ks, omega)
    q_sq = 0.5 * torch.einsum("bhsd,bhsd->bhs", qs, qs)[..., None]
    k_sq = 0.5 * torch.einsum("bhsd,bhsd->bhs", ks, ks)[..., None]
    inv_sqrt_m = float(m) ** -0.5
    phi_q = torch.exp(q_proj - q_sq) * inv_sqrt_m + 1e-6
    phi_k = torch.exp(k_proj - k_sq) * inv_sqrt_m + 1e-6
    kv = torch.einsum("bhsm,bhsd->bhmd", phi_k, v)
    z  = torch.einsum("bhsm->bhm", phi_k)
    num = torch.einsum("bhqm,bhmd->bhqd", phi_q, kv)
    den = torch.einsum("bhqm,bhm->bhq", phi_q, z)[..., None] + 1e-6
    return num / den
```

```asm
; @launch grid=(256,1,1) block=(384,1,1) lds=159808
.amdgcn_target "amdgcn-amd-amdhsa--gfx950"
.text
.globl standalone__linear_kernel_rfa__decode_kernel
.p2align 8
.type standalone__linear_kernel_rfa__decode_kernel,@function
standalone__linear_kernel_rfa__decode_kernel:
    s_load_dwordx8 s[4:11], s[0:1], 0
    s_load_dwordx4 s[12:15], s[0:1], 32
    v_lshrrev_b32 v1, 6, v0
    s_cmp_ge_u32 s2, 256
    v_readfirstlane_b32 s3, v1
    s_cbranch_scc1 L_end0
    v_and_b32 v0, 63, v0
    s_lshr_b32 s59, s2, 3
    s_mov_b32 s58, s2
    s_mov_b32 s2, 0
    s_bfe_u32 s57, s58, 131075
    s_lshl_b32 s57, s57, 0
    s_or_b32 s2, s2, s57
    s_bfe_u32 s57, s58, 65538
    s_lshl_b32 s57, s57, 2
    s_or_b32 s2, s2, s57
    s_bfe_u32 s57, s58, 65537
    s_lshl_b32 s57, s57, 3
    s_or_b32 s2, s2, s57
    s_bfe_u32 s57, s58, 196613
    s_lshl_b32 s57, s57, 4
    s_or_b32 s2, s2, s57
    s_bfe_u32 s57, s58, 65536
    s_lshl_b32 s57, s57, 7
    s_or_b32 s2, s2, s57
    v_lshrrev_b32 v6, 4, v0
    v_and_b32 v7, 15, v0
    v_xor_b32 v2, v6, v7
    v_lshlrev_b32 v2, 4, v2
    v_lshl_add_u32 v2, v6, 8, v2
    v_xor_b32 v3, 64, v2
    v_xor_b32 v4, 0x80, v2
    v_xor_b32 v5, 0xc0, v2
    s_cmp_eq_u32 s3, 0
    s_cbranch_scc1 L_load
    s_cmp_eq_u32 s3, 1
    s_cbranch_scc1 L_ctl
    s_cmp_eq_u32 s3, 2
    s_cbranch_scc1 L_padA
    s_cmp_eq_u32 s3, 3
    s_cbranch_scc1 L_padB
    s_cmp_eq_u32 s3, 4
    s_cbranch_scc1 L_padC
    s_branch L_padD
L_end0:
    s_endpgm
L_load:
    s_setprio 2
    s_mov_b32 s31, 0
    s_bfe_u32 s28, s2, 65536
    s_lshl_b32 s28, s28, 19
    s_xor_b32 s31, s31, s28
    s_lshl_b32 s28, s2, 20
    s_mov_b32 s18, 0x100000
    s_mov_b32 s19, 0x20000
    s_mov_b32 m0, 0
    s_mov_b32 s24, s31
    s_xor_b32 s25, s31, 32768
    s_waitcnt lgkmcnt(0)
    s_add_u32 s16, s6, s28
    s_addc_u32 s17, s7, 0
    buffer_load_dwordx4 v2, s[16:19], s24 offen offset:0 nt lds
    buffer_load_dwordx4 v3, s[16:19], s24 offen offset:1024 nt lds
    buffer_load_dwordx4 v4, s[16:19], s24 offen offset:2048 nt lds
    buffer_load_dwordx4 v5, s[16:19], s24 offen offset:3072 nt lds
    s_mov_b32 m0, 4096
    s_nop 0
    buffer_load_dwordx4 v2, s[16:19], s25 offen offset:0 nt lds
    buffer_load_dwordx4 v3, s[16:19], s25 offen offset:1024 nt lds
    buffer_load_dwordx4 v4, s[16:19], s25 offen offset:2048 nt lds
    buffer_load_dwordx4 v5, s[16:19], s25 offen offset:3072 nt lds
    s_mov_b32 m0, 8192
    s_xor_b32 s24, s31, 8192
    s_xor_b32 s25, s24, 32768
    buffer_load_dwordx4 v2, s[16:19], s24 offen offset:0 nt lds
    buffer_load_dwordx4 v3, s[16:19], s24 offen offset:1024 nt lds
    buffer_load_dwordx4 v4, s[16:19], s24 offen offset:2048 nt lds
    buffer_load_dwordx4 v5, s[16:19], s24 offen offset:3072 nt lds
    s_mov_b32 m0, 12288
    s_nop 0
    buffer_load_dwordx4 v2, s[16:19], s25 offen offset:0 nt lds
    buffer_load_dwordx4 v3, s[16:19], s25 offen offset:1024 nt lds
    buffer_load_dwordx4 v4, s[16:19], s25 offen offset:2048 nt lds
    buffer_load_dwordx4 v5, s[16:19], s25 offen offset:3072 nt lds
    s_mov_b32 m0, 16384
    s_xor_b32 s24, s31, 4096
    s_xor_b32 s25, s24, 32768
    buffer_load_dwordx4 v2, s[16:19], s24 offen offset:0 nt lds
    buffer_load_dwordx4 v3, s[16:19], s24 offen offset:1024 nt lds
    buffer_load_dwordx4 v4, s[16:19], s24 offen offset:2048 nt lds
    buffer_load_dwordx4 v5, s[16:19], s24 offen offset:3072 nt lds
    s_mov_b32 m0, 20480
    s_add_u32 s20, s8, s28
    s_addc_u32 s21, s9, 0
    v_lshlrev_b32 v16, 1, v6
    v_xor_b32 v16, v16, v7
    v_lshlrev_b32 v16, 4, v16
    v_lshl_add_u32 v16, v6, 8, v16
    v_mov_b32 v10, 159744
    s_barrier
    s_waitcnt vmcnt(19)
    buffer_load_dwordx4 v2, s[16:19], s25 offen offset:0 nt lds
    s_waitcnt vmcnt(19)
    buffer_load_dwordx4 v3, s[16:19], s25 offen offset:1024 nt lds
    s_waitcnt vmcnt(19)
    buffer_load_dwordx4 v4, s[16:19], s25 offen offset:2048 nt lds
    s_waitcnt vmcnt(19)
    buffer_load_dwordx4 v5, s[16:19], s25 offen offset:3072 nt lds
    s_xor_b32 s24, s31, 12288
    s_xor_b32 s25, s24, 32768
    s_mov_b32 s27, 24576
    s_mov_b32 s28, 1
    s_mov_b32 s29, 3
    v_mov_b32 v12, 1
L_tile:
    s_cmp_eq_u32 s28, 0
    s_cbranch_scc1 L_lv0
    s_cmp_eq_u32 s28, 2
    s_cbranch_scc1 L_lv2
    s_cmp_eq_u32 s28, 3
    s_cbranch_scc1 L_lv3
L_lv1:
    s_mov_b32 m0, s27
    s_waitcnt vmcnt(19)
    buffer_load_dwordx4 v2, s[16:19], s24 offen offset:0 nt lds
    s_add_u32 s35, s29, 1
    ds_read_b128 v[24:27], v10 offset:16
    ds_read_b32 v14, v10 offset:4
    s_waitcnt vmcnt(19)
    buffer_load_dwordx4 v3, s[16:19], s24 offen offset:1024 nt lds
    s_waitcnt vmcnt(19)
    buffer_load_dwordx4 v4, s[16:19], s24 offen offset:2048 nt lds
    s_waitcnt vmcnt(19)
    ds_write_b32 v10, v12
    buffer_load_dwordx4 v5, s[16:19], s24 offen offset:3072 nt lds
    s_bfe_u32 s30, s35, 65536
    s_lshl_b32 s30, s30, 13
    s_xor_b32 s24, s30, s31
    s_bfe_u32 s30, s35, 65537
    s_lshl_b32 s30, s30, 12
    s_xor_b32 s24, s30, s24
    s_add_u32 m0, s27, 4096
    s_waitcnt vmcnt(19)
    buffer_load_dwordx4 v2, s[16:19], s25 offen offset:0 nt lds
    s_bfe_u32 s30, s35, 262146
    s_lshl_b32 s30, s30, 16
    s_xor_b32 s24, s30, s24
    s_bfe_u32 s30, s35, 65542
    s_lshl_b32 s30, s30, 14
    s_xor_b32 s24, s30, s24
    s_waitcnt vmcnt(19)
    buffer_load_dwordx4 v3, s[16:19], s25 offen offset:1024 nt lds
    s_and_b32 s27, s35, 15
    s_lshl_b32 s27, s27, 13
    s_waitcnt lgkmcnt(1)
    v_min3_u32 v13, v24, v25, v26
    s_waitcnt vmcnt(19)
    buffer_load_dwordx4 v4, s[16:19], s25 offen offset:2048 nt lds
    v_min_u32 v13, v13, v27
    v_readfirstlane_b32 s28, v14
    s_sub_u32 s30, s35, 15
    v_readfirstlane_b32 s26, v13
    s_waitcnt vmcnt(19)
    buffer_load_dwordx4 v5, s[16:19], s25 offen offset:3072 nt lds
    s_branch L_nx
L_lv0:
    s_mov_b32 m0, s27
    s_waitcnt vmcnt(17)
    buffer_load_dwordx4 v2, s[16:19], s24 offen offset:0 nt lds
    s_add_u32 s35, s29, 1
    ds_read_b128 v[24:27], v10 offset:16
    ds_read_b32 v14, v10 offset:4
    s_waitcnt vmcnt(17)
    ds_write_b32 v10, v12
    buffer_load_dwordx4 v3, s[16:19], s24 offen offset:1024 nt lds
    s_waitcnt vmcnt(17)
    buffer_load_dwordx4 v4, s[16:19], s24 offen offset:2048 nt lds
    s_waitcnt vmcnt(17)
    buffer_load_dwordx4 v5, s[16:19], s24 offen offset:3072 nt lds
    s_bfe_u32 s30, s35, 65536
    s_lshl_b32 s30, s30, 13
    s_xor_b32 s24, s30, s31
    s_bfe_u32 s30, s35, 65537
    s_lshl_b32 s30, s30, 12
    s_xor_b32 s24, s30, s24
    s_add_u32 m0, s27, 4096
    s_waitcnt vmcnt(17)
    buffer_load_dwordx4 v2, s[16:19], s25 offen offset:0 nt lds
    s_bfe_u32 s30, s35, 262146
    s_lshl_b32 s30, s30, 16
    s_xor_b32 s24, s30, s24
    s_bfe_u32 s30, s35, 65542
    s_lshl_b32 s30, s30, 14
    s_xor_b32 s24, s30, s24
    s_waitcnt vmcnt(17)
    buffer_load_dwordx4 v3, s[16:19], s25 offen offset:1024 nt lds
    s_and_b32 s27, s35, 15
    s_lshl_b32 s27, s27, 13
    s_waitcnt lgkmcnt(1)
    v_min3_u32 v13, v24, v25, v26
    s_waitcnt vmcnt(17)
    buffer_load_dwordx4 v4, s[16:19], s25 offen offset:2048 nt lds
    v_min_u32 v13, v13, v27
    v_readfirstlane_b32 s28, v14
    s_sub_u32 s30, s35, 15
    v_readfirstlane_b32 s26, v13
    s_waitcnt vmcnt(17)
    buffer_load_dwordx4 v5, s[16:19], s25 offen offset:3072 nt lds
    s_branch L_nx
L_padA:
    s_branch L_cons
L_lv2:
    s_mov_b32 m0, s27
    s_waitcnt vmcnt(21)
    buffer_load_dwordx4 v2, s[16:19], s24 offen offset:0 nt lds
    s_add_u32 s35, s29, 1
    ds_read_b128 v[24:27], v10 offset:16
    ds_read_b32 v14, v10 offset:4
    s_waitcnt vmcnt(21)
    buffer_load_dwordx4 v3, s[16:19], s24 offen offset:1024 nt lds
    s_waitcnt vmcnt(21)
    buffer_load_dwordx4 v4, s[16:19], s24 offen offset:2048 nt lds
    s_waitcnt vmcnt(21)
    buffer_load_dwordx4 v5, s[16:19], s24 offen offset:3072 nt lds
    s_bfe_u32 s30, s35, 65536
    s_lshl_b32 s30, s30, 13
    s_xor_b32 s24, s30, s31
    s_bfe_u32 s30, s35, 65537
    s_lshl_b32 s30, s30, 12
    s_xor_b32 s24, s30, s24
    s_add_u32 m0, s27, 4096
    s_waitcnt vmcnt(21)
    buffer_load_dwordx4 v2, s[16:19], s25 offen offset:0 nt lds
    s_bfe_u32 s30, s35, 262146
    s_lshl_b32 s30, s30, 16
    s_xor_b32 s24, s30, s24
    s_bfe_u32 s30, s35, 65542
    s_lshl_b32 s30, s30, 14
    s_xor_b32 s24, s30, s24
    s_waitcnt vmcnt(21)
    ds_write_b32 v10, v12
    buffer_load_dwordx4 v3, s[16:19], s25 offen offset:1024 nt lds
    s_and_b32 s27, s35, 15
    s_lshl_b32 s27, s27, 13
    s_waitcnt lgkmcnt(1)
    v_min3_u32 v13, v24, v25, v26
    s_waitcnt vmcnt(21)
    buffer_load_dwordx4 v4, s[16:19], s25 offen offset:2048 nt lds
    v_min_u32 v13, v13, v27
    v_readfirstlane_b32 s28, v14
    s_sub_u32 s30, s35, 15
    v_readfirstlane_b32 s26, v13
    s_waitcnt vmcnt(21)
    buffer_load_dwordx4 v5, s[16:19], s25 offen offset:3072 nt lds
    s_branch L_nx
L_lv3:
    s_mov_b32 m0, s27
    s_waitcnt vmcnt(23)
    buffer_load_dwordx4 v2, s[16:19], s24 offen offset:0 nt lds
    s_add_u32 s35, s29, 1
    ds_read_b128 v[24:27], v10 offset:16
    ds_read_b32 v14, v10 offset:4
    s_waitcnt vmcnt(23)
    buffer_load_dwordx4 v3, s[16:19], s24 offen offset:1024 nt lds
    s_waitcnt vmcnt(23)
    buffer_load_dwordx4 v4, s[16:19], s24 offen offset:2048 nt lds
    s_waitcnt vmcnt(23)
    buffer_load_dwordx4 v5, s[16:19], s24 offen offset:3072 nt lds
    s_bfe_u32 s30, s35, 65536
    s_lshl_b32 s30, s30, 13
    s_xor_b32 s24, s30, s31
    s_bfe_u32 s30, s35, 65537
    s_lshl_b32 s30, s30, 12
    s_xor_b32 s24, s30, s24
    s_add_u32 m0, s27, 4096
    s_waitcnt vmcnt(23)
    buffer_load_dwordx4 v2, s[16:19], s25 offen offset:0 nt lds
    s_bfe_u32 s30, s35, 262146
    s_lshl_b32 s30, s30, 16
    s_xor_b32 s24, s30, s24
    s_bfe_u32 s30, s35, 65542
    s_lshl_b32 s30, s30, 14
    s_xor_b32 s24, s30, s24
    s_waitcnt vmcnt(23)
    buffer_load_dwordx4 v3, s[16:19], s25 offen offset:1024 nt lds
    s_and_b32 s27, s35, 15
    s_lshl_b32 s27, s27, 13
    s_waitcnt lgkmcnt(0)
    v_min3_u32 v13, v24, v25, v26
    s_waitcnt vmcnt(23)
    buffer_load_dwordx4 v4, s[16:19], s25 offen offset:2048 nt lds
    v_min_u32 v13, v13, v27
    v_readfirstlane_b32 s28, v14
    s_sub_u32 s30, s35, 15
    v_readfirstlane_b32 s26, v13
    s_waitcnt vmcnt(23)
    ds_write_b32 v10, v12
    buffer_load_dwordx4 v5, s[16:19], s25 offen offset:3072 nt lds
L_nx:
    s_xor_b32 s25, s24, 32768
    v_add_u32 v12, 1, v12
    s_mov_b32 s29, s35
    s_cmp_ge_i32 s26, s30
    s_cbranch_scc0 L_slow
L_free:
    s_and_b32 s30, s29, 127
    s_cbranch_scc1 L_tile
    s_cmp_eq_u32 s29, 256
    s_cbranch_scc1 L_ldone
    v_mov_b32 v2, v16
    v_xor_b32 v3, 0x80, v16
    v_mov_b32 v4, v16
    v_mov_b32 v5, v3
    s_mov_b64 s[16:17], s[20:21]
    s_branch L_tile
L_slow:
    s_cmp_eq_u32 s29, 256
    s_cbranch_scc1 L_ldone
L_slp:
    s_sleep 1
    ds_read_b128 v[24:27], v10 offset:16
    s_waitcnt lgkmcnt(0)
    v_min3_u32 v13, v24, v25, v26
    v_min_u32 v13, v13, v27
    s_nop 0
    v_readfirstlane_b32 s26, v13
    s_cmp_ge_i32 s26, s30
    s_cbranch_scc0 L_slp
    s_branch L_free
L_ldone:
    s_waitcnt vmcnt(16)
    ds_write_b32 v10, v12
    v_add_u32 v12, 1, v12
    s_waitcnt vmcnt(8)
    ds_write_b32 v10, v12
    v_add_u32 v12, 1, v12
    s_waitcnt vmcnt(0)
    ds_write_b32 v10, v12
    s_waitcnt lgkmcnt(0)
    s_endpgm
L_ctl:
    v_lshlrev_b32 v8, 2, v0
    v_add_u32 v8, 159744, v8
    v_cmp_eq_u32 vcc, 1, v0
    v_mov_b32 v9, 1
    s_nop 0
    v_cndmask_b32 v9, 0, v9, vcc
    s_mov_b64 exec, 0xfff
    ds_write_b32 v8, v9
    s_mov_b64 exec, -1
    s_mov_b32 s18, 256
    s_mov_b32 s19, 0x20000
    s_getreg_b32 s20, hwreg(HW_REG_XCC_ID, 0, 3)
    s_mov_b32 s22, 515
    s_cmp_eq_u32 s20, 1
    s_cselect_b32 s22, 457, s22
    s_cmp_eq_u32 s20, 2
    s_cselect_b32 s22, 514, s22
    s_cmp_eq_u32 s20, 3
    s_cselect_b32 s22, 464, s22
    s_cmp_eq_u32 s20, 4
    s_cselect_b32 s22, 540, s22
    s_cmp_eq_u32 s20, 5
    s_cselect_b32 s22, 488, s22
    s_cmp_eq_u32 s20, 6
    s_cselect_b32 s22, 529, s22
    s_cmp_eq_u32 s20, 7
    s_cselect_b32 s22, 465, s22
    s_bfe_u32 s21, s59, 0x40001
    s_add_u32 s22, s22, s21
    s_lshl_b32 s20, s20, 5
    s_add_u32 s21, s59, s20
    v_mov_b32 v8, s21
    v_and_b32 v9, 31, v0
    v_add_u32 v9, s20, v9
    v_mov_b32 v10, 159744
    s_mov_b32 s23, 4
    s_waitcnt lgkmcnt(0)
    s_mov_b32 s16, s14
    s_mov_b32 s17, s15
    buffer_load_ubyte v12, v9, s[16:19], 0 offen sc1
    s_barrier
L_cp:
    ds_read_b32 v11, v10
    s_waitcnt lgkmcnt(0)
    v_readfirstlane_b32 s24, v11
    s_cmp_ge_i32 s24, s23
    s_cbranch_scc1 L_cgo
    s_sleep 2
    s_branch L_cp
L_cgo:
    s_cmp_lg_u32 s23, 8
    s_cbranch_scc1 L_nt
    s_lshl_b32 s28, s2, 20
    s_add_u32 s28, s8, s28
    s_addc_u32 s29, s9, 0
    s_load_dword s30, s[28:29], 0
L_nt:
    v_mov_b32 v11, s23
    s_mov_b64 exec, 1
    buffer_store_byte v11, v8, s[16:19], 0 offen
    s_mov_b64 exec, -1
    s_cmp_eq_u32 s23, 4
    s_cbranch_scc1 L_cn
    buffer_load_ubyte v12, v9, s[16:19], 0 offen nt
    s_waitcnt vmcnt(0)
    v_cmp_ne_u32 vcc, 0, v12
    v_subrev_u32 v12, s23, v12
    v_lshl_add_u32 v12, v12, 2, 6
    v_cndmask_b32 v12, 0, v12, vcc
    s_nop 1
    v_add_u32_dpp v12, v12, v12 row_shr:1 row_mask:0xf bank_mask:0xf bound_ctrl:0
    s_nop 1
    v_add_u32_dpp v12, v12, v12 row_shr:2 row_mask:0xf bank_mask:0xf bound_ctrl:0
    s_nop 1
    v_add_u32_dpp v12, v12, v12 row_shr:4 row_mask:0xf bank_mask:0xf bound_ctrl:0
    s_nop 1
    v_add_u32_dpp v12, v12, v12 row_shr:8 row_mask:0xf bank_mask:0xf bound_ctrl:0
    s_nop 0
    v_readlane_b32 s25, v12, 15
    v_readlane_b32 s26, v12, 31
    s_nop 0
    s_add_i32 s25, s25, s26
    s_add_i32 s25, s25, s22
    s_ashr_i32 s25, s25, 8
    s_max_i32 s25, s25, 0
    s_min_i32 s25, s25, 3
    v_mov_b32 v12, s25
    ds_write_b32 v10, v12 offset:4
L_cn:
    s_add_u32 s23, s23, 4
    s_cmp_eq_u32 s23, 120
    s_cselect_b32 s25, 80, 0
    s_sub_i32 s22, s22, s25
    s_cmp_le_u32 s23, 248
    s_cbranch_scc1 L_cp
    s_waitcnt lgkmcnt(0)
    s_endpgm
L_cons:
    s_sub_u32 s3, s3, 2
    s_lshl_b32 s36, s3, 12
    s_add_u32 m0, s36, 131072
    s_mov_b32 s18, 16384
    s_mov_b32 s19, 0x20000
    s_mov_b32 s22, 256
    s_mov_b32 s23, 0x20000
    s_lshl_b32 s28, s2, 8
    v_lshlrev_b32 v1, 4, v6
    s_waitcnt lgkmcnt(0)
    s_mov_b32 s16, s10
    s_mov_b32 s17, s11
    s_add_u32 s20, s4, s28
    s_addc_u32 s21, s5, 0
    buffer_load_dwordx4 v2, s[16:19], s36 offen offset:0 lds
    buffer_load_dwordx4 v3, s[16:19], s36 offen offset:1024 lds
    buffer_load_dwordx4 v4, s[16:19], s36 offen offset:2048 lds
    buffer_load_dwordx4 v5, s[16:19], s36 offen offset:3072 lds
    s_cmp_lg_u32 s3, 0
    s_cbranch_scc1 L_noq
    s_mov_b32 m0, 147456
    v_lshlrev_b32 v8, 4, v0
    s_mov_b64 exec, 0xffff
    buffer_load_dwordx4 v8, s[20:23], 0 offen lds
    s_mov_b64 exec, -1
L_noq:
    v_add_u32 v1, 147456, v1
    s_barrier
    s_add_u32 s24, s12, s28
    s_addc_u32 s25, s13, 0
    s_mov_b32 s26, 256
    s_mov_b32 s27, 0x20000
    v_mov_b32 v12, 159744
    s_mov_b32 s30, 0x3edb9ada
    s_mov_b32 s32, 0xbd8293ee
    s_mov_b32 s35, 0x358637bd
    v_mov_b32 v198, 0xc0400000
    v_xor_b32 v8, v6, v7
    v_lshlrev_b32 v8, 4, v8
    v_lshl_add_u32 v8, v7, 8, v8
    v_add_u32 v8, 131072, v8
    v_xor_b32 v9, 64, v8
    v_xor_b32 v10, 0x80, v8
    v_xor_b32 v11, 0xc0, v8
    s_lshl_b32 s37, s3, 13
    s_lshl_b32 s29, s3, 6
    s_add_u32 s29, s29, 151552
    v_lshl_add_u32 v196, v6, 4, s29
    s_lshl_b32 s28, s3, 2
    v_add_u32 v197, s28, v12
    v_mov_b32 v200, 0x3f803f80
    v_mov_b32 v201, v200
    v_mov_b32 v202, v200
    v_mov_b32 v203, v200
    v_mov_b32 v13, 1
    v_mov_b32 v14, 0
    s_mov_b64 exec, 1
    s_waitcnt vmcnt(0)
    ds_add_u32 v12, v13 offset:32
    s_mov_b64 exec, -1
L_pom:
    ds_read_b32 v13, v12 offset:32
    s_waitcnt lgkmcnt(0)
    v_readfirstlane_b32 s28, v13
    s_cmp_ge_i32 s28, 4
    s_cbranch_scc1 L_pom_ok
    s_sleep 1
    s_branch L_pom
L_padB:
    s_branch L_cons
L_pom_ok:
    ds_read_b128 v[92:95], v1 offset:0
    ds_read_b128 v[96:99], v1 offset:64
    ds_read_b128 v[100:103], v1 offset:128
    ds_read_b128 v[104:107], v1 offset:192
    ds_read_b128 v[16:19], v8 offset:0
    ds_read_b128 v[20:23], v9 offset:0
    ds_read_b128 v[24:27], v10 offset:0
    ds_read_b128 v[28:31], v11 offset:0
    ds_read_b128 v[32:35], v8 offset:4096
    ds_read_b128 v[36:39], v9 offset:4096
    ds_read_b128 v[40:43], v10 offset:4096
    ds_read_b128 v[44:47], v11 offset:4096
    ds_read_b128 v[48:51], v8 offset:8192
    ds_read_b128 v[52:55], v9 offset:8192
    ds_read_b128 v[56:59], v10 offset:8192
    s_waitcnt lgkmcnt(11)
    v_dot2c_f32_bf16 v14, v92, v92
    v_dot2c_f32_bf16 v14, v93, v93
    v_dot2c_f32_bf16 v14, v94, v94
    v_dot2c_f32_bf16 v14, v95, v95
    v_dot2c_f32_bf16 v14, v96, v96
    v_dot2c_f32_bf16 v14, v97, v97
    v_dot2c_f32_bf16 v14, v98, v98
    v_dot2c_f32_bf16 v14, v99, v99
    v_dot2c_f32_bf16 v14, v100, v100
    v_dot2c_f32_bf16 v14, v101, v101
    v_dot2c_f32_bf16 v14, v102, v102
    v_dot2c_f32_bf16 v14, v103, v103
    v_dot2c_f32_bf16 v14, v104, v104
    v_dot2c_f32_bf16 v14, v105, v105
    v_dot2c_f32_bf16 v14, v106, v106
    v_dot2c_f32_bf16 v14, v107, v107
    s_nop 2
    v_mov_b32 v15, v14
    s_nop 1
    v_permlane32_swap_b32 v14, v15
    v_add_f32 v14, v14, v15
    v_mov_b32 v184, v14
    s_nop 1
    v_permlane16_swap_b32 v14, v184
    v_add_f32 v14, v14, v184
    v_fma_f32 v14, v14, s32, v198
    v_mov_b32 v15, v14
    s_nop 1
    v_permlane32_swap_b32 v14, v15
    ds_read_b128 v[60:63], v11 offset:8192
    ds_read_b128 v[64:67], v8 offset:12288
    ds_read_b128 v[68:71], v9 offset:12288
    ds_read_b128 v[72:75], v10 offset:12288
    ds_read_b128 v[76:79], v11 offset:12288
    s_sub_u32 s28, s37, 131072
    s_waitcnt lgkmcnt(0)
    v_add_u32 v8, s28, v8
    v_add_u32 v9, s28, v9
    v_add_u32 v10, s28, v10
    v_add_u32 v11, s28, v11
    v_mfma_f32_16x16x32_bf16 v[124:127], v[16:19], v[92:95], 0
    v_mfma_f32_16x16x32_bf16 v[124:127], v[20:23], v[96:99], v[124:127]
    v_mfma_f32_16x16x32_bf16 v[124:127], v[24:27], v[100:103], v[124:127]
    v_mfma_f32_16x16x32_bf16 v[124:127], v[28:31], v[104:107], v[124:127]
    v_mfma_f32_16x16x32_bf16 v[128:131], v[32:35], v[92:95], 0
    v_mfma_f32_16x16x32_bf16 v[128:131], v[36:39], v[96:99], v[128:131]
    v_mfma_f32_16x16x32_bf16 v[128:131], v[40:43], v[100:103], v[128:131]
    v_mfma_f32_16x16x32_bf16 v[128:131], v[44:47], v[104:107], v[128:131]
    v_mfma_f32_16x16x32_bf16 v[132:135], v[48:51], v[92:95], 0
    v_mfma_f32_16x16x32_bf16 v[132:135], v[52:55], v[96:99], v[132:135]
    v_mfma_f32_16x16x32_bf16 v[132:135], v[56:59], v[100:103], v[132:135]
    v_mfma_f32_16x16x32_bf16 v[132:135], v[60:63], v[104:107], v[132:135]
    v_mfma_f32_16x16x32_bf16 v[136:139], v[64:67], v[92:95], 0
    v_mfma_f32_16x16x32_bf16 v[136:139], v[68:71], v[96:99], v[136:139]
    v_mfma_f32_16x16x32_bf16 v[136:139], v[72:75], v[100:103], v[136:139]
    v_mfma_f32_16x16x32_bf16 v[136:139], v[76:79], v[104:107], v[136:139]
    v_fma_f32 v124, v124, s30, v14
    v_fma_f32 v125, v125, s30, v14
    v_fma_f32 v126, v126, s30, v14
    v_fma_f32 v127, v127, s30, v14
    v_fma_f32 v128, v128, s30, v14
    v_fma_f32 v129, v129, s30, v14
    v_fma_f32 v130, v130, s30, v14
    v_fma_f32 v131, v131, s30, v14
    v_fma_f32 v132, v132, s30, v14
    v_fma_f32 v133, v133, s30, v14
    v_fma_f32 v134, v134, s30, v14
    v_fma_f32 v135, v135, s30, v14
    v_fma_f32 v136, v136, s30, v14
    v_fma_f32 v137, v137, s30, v14
    v_fma_f32 v138, v138, s30, v14
    v_fma_f32 v139, v139, s30, v14
    v_exp_f32 v124, v124
    v_exp_f32 v125, v125
    v_exp_f32 v126, v126
    v_exp_f32 v127, v127
    v_exp_f32 v128, v128
    v_exp_f32 v129, v129
    v_exp_f32 v130, v130
    v_exp_f32 v131, v131
    v_exp_f32 v132, v132
    v_exp_f32 v133, v133
    v_exp_f32 v134, v134
    v_exp_f32 v135, v135
    v_exp_f32 v136, v136
    v_exp_f32 v137, v137
    v_exp_f32 v138, v138
    v_exp_f32 v139, v139
    v_add_f32 v124, s35, v124
    v_add_f32 v125, s35, v125
    v_add_f32 v126, s35, v126
    v_add_f32 v127, s35, v127
    v_add_f32 v128, s35, v128
    v_add_f32 v129, s35, v129
    v_add_f32 v130, s35, v130
    v_add_f32 v131, s35, v131
    v_add_f32 v132, s35, v132
    v_add_f32 v133, s35, v133
    v_add_f32 v134, s35, v134
    v_add_f32 v135, s35, v135
    v_add_f32 v136, s35, v136
    v_add_f32 v137, s35, v137
    v_add_f32 v138, s35, v138
    v_add_f32 v139, s35, v139
    v_cvt_pk_bf16_f32 v80, v124, v125
    v_cvt_pk_bf16_f32 v81, v126, v127
    v_cvt_pk_bf16_f32 v82, v128, v129
    v_cvt_pk_bf16_f32 v83, v130, v131
    v_cvt_pk_bf16_f32 v84, v132, v133
    v_cvt_pk_bf16_f32 v85, v134, v135
    v_cvt_pk_bf16_f32 v86, v136, v137
    v_cvt_pk_bf16_f32 v87, v138, v139
    v_mfma_f32_16x16x32_bf16 v[88:91], v[200:203], v[80:83], 0
    s_nop 0
    v_mfma_f32_16x16x32_bf16 v[88:91], v[200:203], v[84:87], v[88:91]
    s_mul_i32 s36, s3, 3
    s_add_u32 s36, s36, 3
    s_mov_b32 s39, s3
    s_mov_b32 s38, 0x8000
    s_mov_b32 s42, 0x00010001
    s_mov_b32 s43, s42
    s_nop 1
    v_mul_f32 v88, s35, v88
    v_mul_f32 v89, s35, v89
    v_mul_f32 v90, s35, v90
    v_mul_f32 v91, s35, v91
L_ck:
    ds_read_b32 v13, v12 offset:0
    s_waitcnt lgkmcnt(0)
    v_readfirstlane_b32 s28, v13
    s_cmp_ge_i32 s28, s36
    s_cbranch_scc1 L_ck_ok
    s_sleep 1
    s_branch L_ck
L_padC:
    s_branch L_cons
L_ck_ok:
    ds_read_b128 v[92:95], v8 offset:0
    ds_read_b128 v[96:99], v9 offset:0
    ds_read_b128 v[100:103], v10 offset:0
    ds_read_b128 v[104:107], v11 offset:0
    ds_read_b128 v[108:111], v8 offset:4096
    ds_read_b128 v[112:115], v9 offset:4096
    ds_read_b128 v[116:119], v10 offset:4096
    ds_read_b128 v[120:123], v11 offset:4096
    s_add_u32 s39, s39, 4
    s_add_u32 s36, s36, 4
    s_min_u32 s28, s39, 128
    v_mov_b32 v13, s28
    v_xor_b32 v8, s38, v8
    v_xor_b32 v9, s38, v9
    v_xor_b32 v10, s38, v10
    v_xor_b32 v11, s38, v11
    s_xor_b32 s38, s38, 0x10000
    v_mov_b32 v14, 0
    v_mov_b32 v15, 0
    s_waitcnt lgkmcnt(4)
    v_mfma_f32_16x16x32_bf16 v[124:127], v[16:19], v[92:95], 0
    v_dot2c_f32_bf16 v14, v92, v92
    v_dot2c_f32_bf16 v14, v93, v93
    v_mfma_f32_16x16x32_bf16 v[124:127], v[20:23], v[96:99], v[124:127]
    v_dot2c_f32_bf16 v14, v94, v94
    v_dot2c_f32_bf16 v14, v95, v95
    v_mfma_f32_16x16x32_bf16 v[124:127], v[24:27], v[100:103], v[124:127]
    s_waitcnt lgkmcnt(0)
    ds_write_b32 v197, v13 offset:16
    v_dot2c_f32_bf16 v14, v96, v96
    v_dot2c_f32_bf16 v14, v97, v97
    v_mfma_f32_16x16x32_bf16 v[124:127], v[28:31], v[104:107], v[124:127]
    v_dot2c_f32_bf16 v14, v98, v98
    v_dot2c_f32_bf16 v14, v99, v99
    v_mfma_f32_16x16x32_bf16 v[128:131], v[32:35], v[92:95], 0
    v_dot2c_f32_bf16 v14, v100, v100
    v_dot2c_f32_bf16 v14, v101, v101
    v_mfma_f32_16x16x32_bf16 v[128:131], v[36:39], v[96:99], v[128:131]
    v_dot2c_f32_bf16 v14, v102, v102
    v_dot2c_f32_bf16 v14, v103, v103
    v_mfma_f32_16x16x32_bf16 v[128:131], v[40:43], v[100:103], v[128:131]
    v_dot2c_f32_bf16 v14, v104, v104
    v_dot2c_f32_bf16 v14, v105, v105
    v_mfma_f32_16x16x32_bf16 v[128:131], v[44:47], v[104:107], v[128:131]
    v_dot2c_f32_bf16 v14, v106, v106
    v_dot2c_f32_bf16 v14, v107, v107
    v_mfma_f32_16x16x32_bf16 v[132:135], v[48:51], v[92:95], 0
    v_dot2c_f32_bf16 v15, v108, v108
    v_dot2c_f32_bf16 v15, v109, v109
    v_mfma_f32_16x16x32_bf16 v[132:135], v[52:55], v[96:99], v[132:135]
    v_dot2c_f32_bf16 v15, v110, v110
    v_dot2c_f32_bf16 v15, v111, v111
    v_mfma_f32_16x16x32_bf16 v[132:135], v[56:59], v[100:103], v[132:135]
    v_dot2c_f32_bf16 v15, v112, v112
    v_dot2c_f32_bf16 v15, v113, v113
    v_mfma_f32_16x16x32_bf16 v[132:135], v[60:63], v[104:107], v[132:135]
    v_dot2c_f32_bf16 v15, v114, v114
    v_dot2c_f32_bf16 v15, v115, v115
    v_mfma_f32_16x16x32_bf16 v[136:139], v[64:67], v[92:95], 0
    v_dot2c_f32_bf16 v15, v116, v116
    v_dot2c_f32_bf16 v15, v117, v117
    v_mfma_f32_16x16x32_bf16 v[136:139], v[68:71], v[96:99], v[136:139]
    v_dot2c_f32_bf16 v15, v118, v118
    v_dot2c_f32_bf16 v15, v119, v119
    v_mfma_f32_16x16x32_bf16 v[136:139], v[72:75], v[100:103], v[136:139]
    v_dot2c_f32_bf16 v15, v120, v120
    v_dot2c_f32_bf16 v15, v121, v121
    v_mfma_f32_16x16x32_bf16 v[136:139], v[76:79], v[104:107], v[136:139]
    v_dot2c_f32_bf16 v15, v122, v122
    v_dot2c_f32_bf16 v15, v123, v123
    s_nop 2
    v_permlane32_swap_b32 v14, v15
    v_add_f32 v14, v14, v15
    v_mov_b32 v184, v14
    s_nop 1
    v_permlane16_swap_b32 v14, v184
    v_add_f32 v14, v14, v184
    v_fma_f32 v14, v14, s32, v198
    v_mov_b32 v15, v14
    s_nop 1
    v_permlane32_swap_b32 v14, v15
    v_mfma_f32_16x16x32_bf16 v[140:143], v[16:19], v[108:111], 0
    v_fma_f32 v124, v124, s30, v14
    v_fma_f32 v125, v125, s30, v14
    v_mfma_f32_16x16x32_bf16 v[140:143], v[20:23], v[112:115], v[140:143]
    v_fma_f32 v126, v126, s30, v14
    v_fma_f32 v127, v127, s30, v14
    v_exp_f32 v124, v124
    v_mfma_f32_16x16x32_bf16 v[140:143], v[24:27], v[116:119], v[140:143]
    v_exp_f32 v125, v125
    v_exp_f32 v126, v126
    v_mfma_f32_16x16x32_bf16 v[140:143], v[28:31], v[120:123], v[140:143]
    v_exp_f32 v127, v127
    v_fma_f32 v128, v128, s30, v14
    v_fma_f32 v129, v129, s30, v14
    v_mfma_f32_16x16x32_bf16 v[144:147], v[32:35], v[108:111], 0
    v_fma_f32 v130, v130, s30, v14
    v_fma_f32 v131, v131, s30, v14
    v_mfma_f32_16x16x32_bf16 v[144:147], v[36:39], v[112:115], v[144:147]
    v_cvt_pk_bf16_f32 v156, v124, v125
    v_cvt_pk_bf16_f32 v157, v126, v127
    v_exp_f32 v128, v128
    v_mfma_f32_16x16x32_bf16 v[144:147], v[40:43], v[116:119], v[144:147]
    v_exp_f32 v129, v129
    v_exp_f32 v130, v130
    v_mfma_f32_16x16x32_bf16 v[144:147], v[44:47], v[120:123], v[144:147]
    v_exp_f32 v131, v131
    v_fma_f32 v132, v132, s30, v14
    v_fma_f32 v133, v133, s30, v14
    v_mfma_f32_16x16x32_bf16 v[148:151], v[48:51], v[108:111], 0
    v_fma_f32 v134, v134, s30, v14
    v_fma_f32 v135, v135, s30, v14
    v_mfma_f32_16x16x32_bf16 v[148:151], v[52:55], v[112:115], v[148:151]
    v_cvt_pk_bf16_f32 v158, v128, v129
    v_cvt_pk_bf16_f32 v159, v130, v131
    v_exp_f32 v132, v132
    v_mfma_f32_16x16x32_bf16 v[148:151], v[56:59], v[116:119], v[148:151]
    v_exp_f32 v133, v133
    v_exp_f32 v134, v134
    v_mfma_f32_16x16x32_bf16 v[148:151], v[60:63], v[120:123], v[148:151]
    v_exp_f32 v135, v135
    v_fma_f32 v136, v136, s30, v14
    v_fma_f32 v137, v137, s30, v14
    v_mfma_f32_16x16x32_bf16 v[152:155], v[64:67], v[108:111], 0
    v_fma_f32 v138, v138, s30, v14
    v_fma_f32 v139, v139, s30, v14
    v_mfma_f32_16x16x32_bf16 v[152:155], v[68:71], v[112:115], v[152:155]
    v_cvt_pk_bf16_f32 v160, v132, v133
    v_cvt_pk_bf16_f32 v161, v134, v135
    v_exp_f32 v136, v136
    v_mfma_f32_16x16x32_bf16 v[152:155], v[72:75], v[116:119], v[152:155]
    v_exp_f32 v137, v137
    v_exp_f32 v138, v138
    v_mfma_f32_16x16x32_bf16 v[152:155], v[76:79], v[120:123], v[152:155]
    v_exp_f32 v139, v139
    v_cvt_pk_bf16_f32 v162, v136, v137
    v_cvt_pk_bf16_f32 v163, v138, v139
    v_fma_f32 v140, v140, s30, v15
    v_fma_f32 v141, v141, s30, v15
    v_fma_f32 v142, v142, s30, v15
    v_fma_f32 v143, v143, s30, v15
    v_exp_f32 v140, v140
    v_exp_f32 v141, v141
    s_branch L_padsD
L_padD:
    s_branch L_cons
L_padsD:
    v_mfma_f32_16x16x32_bf16 v[172:175], v[156:159], v[80:83], v[88:91]
    v_exp_f32 v142, v142
    v_exp_f32 v143, v143
    v_fma_f32 v144, v144, s30, v15
    v_fma_f32 v145, v145, s30, v15
    v_mfma_f32_16x16x32_bf16 v[172:175], v[160:163], v[84:87], v[172:175]
    v_fma_f32 v146, v146, s30, v15
    v_fma_f32 v147, v147, s30, v15
    v_cvt_pk_bf16_f32 v164, v140, v141
    v_cvt_pk_bf16_f32 v165, v142, v143
    v_exp_f32 v144, v144
    v_exp_f32 v145, v145
    v_exp_f32 v146, v146
    v_exp_f32 v147, v147
    v_fma_f32 v148, v148, s30, v15
    v_fma_f32 v149, v149, s30, v15
    v_fma_f32 v150, v150, s30, v15
    v_fma_f32 v151, v151, s30, v15
    v_cvt_pk_bf16_f32 v166, v144, v145
    v_cvt_pk_bf16_f32 v167, v146, v147
    v_exp_f32 v148, v148
    v_exp_f32 v149, v149
    v_exp_f32 v150, v150
    v_exp_f32 v151, v151
    v_fma_f32 v152, v152, s30, v15
    v_fma_f32 v153, v153, s30, v15
    v_fma_f32 v154, v154, s30, v15
    v_fma_f32 v155, v155, s30, v15
    v_cvt_pk_bf16_f32 v168, v148, v149
    v_cvt_pk_bf16_f32 v169, v150, v151
    v_exp_f32 v152, v152
    v_exp_f32 v153, v153
    v_exp_f32 v154, v154
    v_exp_f32 v155, v155
    v_cvt_pk_bf16_f32 v170, v152, v153
    v_cvt_pk_bf16_f32 v171, v154, v155
    v_mfma_f32_16x16x32_bf16 v[176:179], v[164:167], v[80:83], v[88:91]
    s_nop 0
    v_mfma_f32_16x16x32_bf16 v[176:179], v[168:171], v[84:87], v[176:179]
    v_cvt_pk_bf16_f32 v180, v172, v173
    v_cvt_pk_bf16_f32 v181, v174, v175
    s_nop 5
    v_cvt_pk_bf16_f32 v182, v176, v177
    v_cvt_pk_bf16_f32 v183, v178, v179
    s_mov_b64 exec, s[42:43]
    ds_write_b128 v196, v[180:183]
    s_mov_b64 exec, -1
    v_add_u32 v196, 0x100, v196
    s_cmp_lt_u32 s39, 128
    s_cbranch_scc1 L_ck
    s_mov_b32 s36, 129
    s_mov_b32 s38, 0
    v_lshlrev_b32 v196, 4, v6
    v_add_u32 v196, 151552, v196
    v_lshrrev_b32 v1, 2, v0
    v_and_b32 v52, 7, v1
    v_lshlrev_b32 v52, 5, v52
    v_lshl_add_u32 v52, v1, 8, v52
    v_and_b32 v1, 3, v0
    v_lshl_add_u32 v52, v1, 3, v52
    s_lshl_b32 s28, s3, 6
    v_xor_b32 v52, s28, v52
    v_xor_b32 v53, 32, v52
    v_mov_b32 v54, v52
    v_mov_b32 v55, v53
    v_mov_b64 v[16:17], 0
    v_mov_b64 v[18:19], 0
    v_mov_b64 v[20:21], 0
    v_mov_b64 v[22:23], 0
    v_mov_b64 v[24:25], 0
    v_mov_b64 v[26:27], 0
    v_lshlrev_b32 v4, 5, v7
    v_lshl_add_u32 v4, v6, 3, v4
    v_add_u32 v4, s28, v4
    s_mov_b32 s42, 0x00030003
    s_mov_b32 s43, s42
    v_cmp_eq_u32 vcc, 1, v7
L_cv:
    ds_read_b128 v[180:183], v196
L_pv:
    ds_read_b32 v13, v12 offset:0
    s_waitcnt lgkmcnt(0)
    v_readfirstlane_b32 s28, v13
    s_cmp_ge_i32 s28, s36
    s_cbranch_scc1 L_pv_ok
    s_sleep 1
    s_branch L_pv
L_pv_ok:
    ds_read_b64_tr_b16 v[92:93], v54 offset:0
    ds_read_b64_tr_b16 v[94:95], v54 offset:4096
    ds_read_b64_tr_b16 v[96:97], v55 offset:0
    ds_read_b64_tr_b16 v[98:99], v55 offset:4096
    v_mfma_f32_16x16x32_bf16 v[24:27], v[200:203], v[180:183], v[24:27]
    v_mov_b32 v13, s36
    s_add_u32 s36, s36, 1
    s_add_u32 s38, s38, 0x2000
    s_and_b32 s38, s38, 0x1ffff
    s_waitcnt lgkmcnt(2)
    v_mfma_f32_16x16x32_bf16 v[16:19], v[92:95], v[180:183], v[16:19]
    s_waitcnt lgkmcnt(0)
    v_mfma_f32_16x16x32_bf16 v[20:23], v[96:99], v[180:183], v[20:23]
    ds_write_b32 v197, v13 offset:16
    v_add_u32 v54, s38, v52
    v_add_u32 v55, s38, v53
    v_add_u32 v196, 64, v196
    s_cmp_le_u32 s36, 256
    s_cbranch_scc1 L_cv
    v_add_f32 v184, s35, v24
    v_rcp_f32 v184, v184
    v_cndmask_b32 v16, v16, v20, vcc
    v_cndmask_b32 v17, v17, v21, vcc
    v_cndmask_b32 v18, v18, v22, vcc
    v_cndmask_b32 v19, v19, v23, vcc
    v_mul_f32 v16, v16, v184
    v_mul_f32 v17, v17, v184
    v_mul_f32 v18, v18, v184
    v_mul_f32 v19, v19, v184
    v_cvt_pk_bf16_f32 v16, v16, v17
    v_cvt_pk_bf16_f32 v17, v18, v19
    s_mov_b64 exec, s[42:43]
    buffer_store_dwordx2 v[16:17], v4, s[24:27], 0 offen
L_end:
    s_endpgm
.section .rodata,"a"
.p2align 6
.amdhsa_kernel standalone__linear_kernel_rfa__decode_kernel
  .amdhsa_next_free_vgpr 204
  .amdhsa_next_free_sgpr 64
  .amdhsa_accum_offset 204
  .amdhsa_group_segment_fixed_size 0
  .amdhsa_kernarg_size 56
  .amdhsa_user_sgpr_count 2
  .amdhsa_user_sgpr_kernarg_segment_ptr 1
  .amdhsa_system_sgpr_workgroup_id_x 1
.end_amdhsa_kernel
```
